```python
import torch

def _softmax(x, axis=-1):
    return torch.softmax(x, dim=axis)
def _gelu(x):
    return torch.nn.functional.gelu(x, approximate="tanh")
def _silu(x):
    return torch.nn.functional.silu(x)
def _sigmoid(x):
    return torch.sigmoid(x)
def _layernorm(x, axis=-1, eps=1e-5):
    m = x.mean(dim=axis, keepdim=True)
    v = x.var(dim=axis, keepdim=True, unbiased=False)
    return (x - m) / torch.sqrt(v + eps)
def _scatter_add(tgt, idx, src, axis=0):
    return tgt.clone().index_add_(axis, idx, src)
def _segment_sum(src, seg, n):
    out = torch.zeros((n,) + src.shape[1:], dtype=src.dtype)
    return out.index_add_(0, seg, src)
def _pad(x, pw):
    flat = tuple(v for pair in reversed(pw) for v in pair)
    return torch.nn.functional.pad(x, flat)

kernel_name = 'standalone__spectral_conv_sgc__graph'

def setup_inputs():

    _w = (lambda a: (lambda t: t.to(torch.bfloat16) if t.is_floating_point() else t)(torch.as_tensor(a)))
    N, deg, D = 50000, 16, 64
    E = N * deg
    rs = (lambda lo, hi, *s: torch.randint(lo, hi, s))(0, N, E).to(torch.int64)
    rd = (lambda lo, hi, *s: torch.randint(lo, hi, s))(0, N, E).to(torch.int64)
    loop = torch.arange(N).to(torch.int64)
    src = torch.cat([rs, loop])
    dst = torch.cat([rd, loop])
    deg_cnt = torch.bincount(dst, minlength=N).to(float)
    dis = 1.0 / (lambda _x: torch.sqrt(torch.as_tensor(_x)))(deg_cnt)
    return {
        "x": _w((lambda *s: torch.randn(*s, dtype=torch.bfloat16) * 0.05)(N, D)),
        "src": _w(src),
        "dst": _w(dst),
        "norm": _w((dis[src] * dis[dst]).to(float)),
        "w": _w((lambda *s: torch.randn(*s, dtype=torch.bfloat16) * 0.05)(D, D)),
    }

def reference(x, src, dst, norm, w):
    N = x.shape[0]
    h = x
    for _ in range(2):
        msg = h[src] * norm[:, None]
        h = _segment_sum(msg, dst, N)
    return h @ w
```

```asm
; @launch grid=(256,1,1) block=(1024,1,1) lds=114432
.amdgcn_target "amdgcn-amd-amdhsa--gfx950"
.text
.globl standalone__spectral_conv_sgc__graph_kernel
.p2align 8
.type standalone__spectral_conv_sgc__graph_kernel,@function
standalone__spectral_conv_sgc__graph_kernel:
s_load_dwordx2 s[20:21], s[0:1], 16
s_load_dwordx2 s[24:25], s[0:1], 8
s_load_dwordx2 s[4:5], s[0:1], 24
s_cmpk_ge_u32 s2, 256
s_cbranch_scc1 L_END
s_load_dwordx2 s[12:13], s[0:1], 56
s_load_dwordx2 s[16:17], s[0:1], 48
s_getpc_b64 s[54:55]
L_PC0:
v_lshlrev_b32 v43, 7, v0
v_cmp_gt_u32 vcc, L_END-L_PC0, v43
s_and_saveexec_b64 s[40:41], vcc
s_cbranch_execz L_NOCPF
global_load_dword v31, v43, s[54:55]
L_NOCPF:
s_mov_b64 exec, -1
v_mov_b32 v8, 0
v_mov_b32 v9, 0
v_mov_b32 v10, 0
v_mov_b32 v11, 0
v_lshlrev_b32 v54, 4, v0
ds_write_b128 v54, v[8:11] offset:18432
s_lshl_b32 s34, s2, 4
v_and_or_b32 v41, v0, 15, s34
v_lshrrev_b32 v40, 4, v0
v_lshl_add_u32 v40, v40, 12, v41
v_and_b32 v41, 16, v0
v_mul_u32_u24 v41, 96, v41
v_xor_b32 v40, v40, v41
v_lshlrev_b32 v41, 4, v40
s_mov_b32 s22, 0x33e140
s_mov_b32 s23, 0x20000
s_waitcnt lgkmcnt(0)
buffer_load_dwordx4 v[44:47], v41, s[20:23], 0 offen
v_lshrrev_b32 v42, 1, v41
s_mov_b64 s[26:27], s[22:23]
s_lshr_b32 s6, s22, 1
s_mov_b32 s7, s23
v_cmp_gt_u32 vcc, 832, v0
s_mov_b32 s14, 0x1800000
s_mov_b32 s15, s23
s_and_b32 s34, s2, 0xc7
s_waitcnt lgkmcnt(0)
s_cbranch_vccz L_H0
s_barrier
buffer_load_dwordx4 v[48:51], v41, s[24:27], 0 offen
buffer_load_dwordx2 v[52:53], v42, s[4:7], 0 offen
s_branch L_E0
L_H0:
s_movk_i32 s18, 256
s_mov_b32 s19, s23
s_cbranch_scc1 L_H05
v_cmp_gt_u32 vcc, 960, v0
s_cbranch_vccnz L_H05
s_lshl_b32 s34, s2, 10
s_add_u32 s34, s34, 0x73c400
s_add_u32 s35, s34, 8192
L_ZLOOP:
buffer_store_dwordx4 v[8:11], v54, s[12:15], s34 offen sc1
s_addk_i32 s34, 1024
s_cmp_lt_u32 s34, s35
s_cbranch_scc1 L_ZLOOP
L_H05:
buffer_load_dword v31, v8, s[16:19], 0 offen offset:128
L_H1:
s_barrier
s_branch L_P1H1
L_E0:
ds_write_b128 v54, v[8:11] offset:34816
ds_write_b128 v54, v[8:11] offset:45824
v_cmp_gt_u32 vcc, 212500, v40
v_mov_b32 v7, 1
s_mov_b32 s40, -196
s_mov_b32 s41, 0x05040100
s_mov_b32 s42, 0x07060100
v_mov_b32 v43, 27148
v_mul_u32_u24 v80, 24, v0
v_add_u32 v80, 28416, v80
v_add_u32 v81, 19968, v80
s_mul_i32 s34, s2, 20480
v_lshl_add_u32 v41, v0, 4, s34
v_add_u32 v42, 13312, v41
v_add_u32 v82, 832, v0
s_mov_b64 exec, vcc
s_waitcnt vmcnt(2)
v_mul_u32_u24 v74, 85599, v44
v_mul_u32_u24 v75, 85599, v45
v_mul_u32_u24 v76, 85599, v46
v_mul_u32_u24 v77, 85599, v47
v_lshrrev_b32 v70, 24, v74
v_lshlrev_b32 v54, 2, v70
ds_add_rtn_u32 v58, v54, v7 offset:27392
v_lshrrev_b32 v71, 24, v75
v_lshlrev_b32 v55, 2, v71
ds_add_rtn_u32 v59, v55, v7 offset:27392
v_lshrrev_b32 v72, 24, v76
v_lshlrev_b32 v56, 2, v72
ds_add_rtn_u32 v60, v56, v7 offset:27392
v_lshrrev_b32 v73, 24, v77
v_lshlrev_b32 v57, 2, v73
ds_add_rtn_u32 v61, v57, v7 offset:27392
s_waitcnt lgkmcnt(0)
s_barrier
v_mad_i32_i24 v44, v70, s40, v44
v_and_b32 v74, 0xe0000000, v74
v_add_u32 v44, 1, v44
v_mad_i32_i24 v45, v71, s40, v45
v_and_b32 v75, 0xe0000000, v75
v_add_u32 v45, 1, v45
v_mad_i32_i24 v46, v72, s40, v46
v_and_b32 v76, 0xe0000000, v76
v_add_u32 v46, 1, v46
v_mad_i32_i24 v47, v73, s40, v47
v_and_b32 v77, 0xe0000000, v77
v_add_u32 v47, 1, v47
s_barrier
ds_read_b32 v54, v54 offset:27392
ds_read_b32 v55, v55 offset:27392
ds_read_b32 v56, v56 offset:27392
ds_read_b32 v57, v57 offset:27392
s_mov_b64 exec, -1
ds_read_b32 v43, v43
s_mov_b64 exec, vcc
s_waitcnt vmcnt(1)
v_mul_u32_u24 v78, 85599, v48
v_sub_u32 v78, v78, v74
v_bfe_u32 v78, v78, 29, 2
v_lshl_or_b32 v63, v44, 2, v78
v_mul_u32_u24 v78, 85599, v49
v_sub_u32 v78, v78, v75
v_bfe_u32 v78, v78, 29, 2
v_lshl_or_b32 v65, v45, 2, v78
v_mul_u32_u24 v78, 85599, v50
v_sub_u32 v78, v78, v76
v_bfe_u32 v78, v78, 29, 2
v_lshl_or_b32 v67, v46, 2, v78
v_mul_u32_u24 v78, 85599, v51
v_sub_u32 v78, v78, v77
v_bfe_u32 v78, v78, 29, 2
v_lshl_or_b32 v69, v47, 2, v78
s_waitcnt vmcnt(0)
v_perm_b32 v62, v52, v48, s41
v_perm_b32 v64, v52, v49, s42
v_perm_b32 v66, v53, v50, s41
v_perm_b32 v68, v53, v51, s42
s_waitcnt lgkmcnt(4)
v_lshl_add_u32 v58, v58, 3, v54
ds_write_b64 v58, v[62:63] offset:28416
s_waitcnt lgkmcnt(4)
v_lshl_add_u32 v59, v59, 3, v55
ds_write_b64 v59, v[64:65] offset:28416
s_waitcnt lgkmcnt(4)
v_lshl_add_u32 v60, v60, 3, v56
ds_write_b64 v60, v[66:67] offset:28416
s_waitcnt lgkmcnt(4)
v_lshl_add_u32 v61, v61, 3, v57
ds_write_b64 v61, v[68:69] offset:28416
s_mov_b64 exec, -1
s_waitcnt lgkmcnt(0)
v_cmp_lt_u32 vcc, v82, v43
s_barrier
ds_read_b64 v[44:45], v80
ds_read_b64 v[48:49], v80 offset:8
ds_read_b64 v[46:47], v80 offset:16
s_cbranch_vccz L_ST1
s_mov_b64 exec, vcc
ds_read_b64 v[56:57], v81
ds_read_b64 v[60:61], v81 offset:8
ds_read_b64 v[58:59], v81 offset:16
s_waitcnt lgkmcnt(0)
v_lshl_or_b32 v59, v59, 10, v61
v_lshl_or_b32 v59, v59, 10, v57
v_mov_b32 v57, v60
buffer_store_dwordx4 v[56:59], v42, s[12:15], 0 offen sc1
s_mov_b64 exec, -1
L_ST1:
s_waitcnt lgkmcnt(0)
v_lshl_or_b32 v47, v47, 10, v49
v_lshl_or_b32 v47, v47, 10, v45
v_mov_b32 v45, v48
buffer_store_dwordx4 v[44:47], v41, s[12:15], 0 offen sc1
s_branch L_P1_JOIN
L_P1H1:
v_and_b32 v1, 63, v0
v_and_b32 v40, 7, v0
v_lshlrev_b32 v6, 4, v40
v_mov_b32 v7, 1
v_cmp_gt_u32 vcc, 960, v0
s_cbranch_vccnz L_P1H2
s_and_b32 s34, s2, 0xc7
s_cbranch_scc1 L_W15_B
v_mov_b32 v56, 1
v_mov_b32 v57, 1
v_mov_b32 v58, 1
v_mov_b32 v59, 1
s_lshl_b32 s34, s2, 1
s_mov_b64 exec, 1
s_waitcnt vmcnt(1)
buffer_store_dwordx4 v[56:59], v6, s[16:19], s34 offen sc1
L_W15_B:
s_lshl_b32 s34, s2, 8
s_add_u32 s34, s34, 0x75c400
s_add_u32 s35, s34, 0x10000
s_mov_b64 exec, 0xffff
buffer_store_dwordx4 v[8:11], v54, s[12:15], s34 offen sc1
s_cmp_ge_u32 s2, 8
s_cbranch_scc1 L_W15_C
buffer_store_dwordx4 v[8:11], v54, s[12:15], s35 offen sc1
L_W15_C:
s_mov_b64 exec, -1
s_barrier
s_barrier
s_barrier
s_waitcnt lgkmcnt(0)
s_branch L_P1_JOIN
L_P1H2:
s_load_dwordx2 s[60:61], s[0:1], 32
v_cmp_gt_u32 vcc, 896, v0
s_waitcnt lgkmcnt(0)
s_cbranch_vccnz L_P1_W13
s_mov_b32 s20, s60
s_mov_b32 s21, s61
s_mov_b32 s22, 0x2000
s_mov_b32 s23, 0x20000
v_lshlrev_b32 v40, 4, v1
v_add_u32 v41, 4096, v40
buffer_load_dwordx4 v[88:91], v40, s[20:23], 0 offen offset:0
buffer_load_dwordx4 v[92:95], v40, s[20:23], 0 offen offset:1024
buffer_load_dwordx4 v[96:99], v40, s[20:23], 0 offen offset:2048
buffer_load_dwordx4 v[100:103], v40, s[20:23], 0 offen offset:3072
buffer_load_dwordx4 v[104:107], v41, s[20:23], 0 offen offset:0
buffer_load_dwordx4 v[108:111], v41, s[20:23], 0 offen offset:1024
buffer_load_dwordx4 v[112:115], v41, s[20:23], 0 offen offset:2048
buffer_load_dwordx4 v[116:119], v41, s[20:23], 0 offen offset:3072
s_barrier
s_barrier
s_barrier
s_waitcnt vmcnt(0)
v_lshrrev_b32 v38, 3, v1
v_lshl_add_u32 v38, v38, 1, v6
ds_write_b16 v38, v88 offset:10240
ds_write_b16_d16_hi v38, v88 offset:12288
ds_write_b16 v38, v89 offset:14336
ds_write_b16_d16_hi v38, v89 offset:16384
ds_write_b16 v38, v90 offset:10368
ds_write_b16_d16_hi v38, v90 offset:12416
ds_write_b16 v38, v91 offset:14464
ds_write_b16_d16_hi v38, v91 offset:16512
ds_write_b16 v38, v92 offset:10496
ds_write_b16_d16_hi v38, v92 offset:12544
ds_write_b16 v38, v93 offset:14592
ds_write_b16_d16_hi v38, v93 offset:16640
ds_write_b16 v38, v94 offset:10624
ds_write_b16_d16_hi v38, v94 offset:12672
ds_write_b16 v38, v95 offset:14720
ds_write_b16_d16_hi v38, v95 offset:16768
ds_write_b16 v38, v96 offset:10752
ds_write_b16_d16_hi v38, v96 offset:12800
ds_write_b16 v38, v97 offset:14848
ds_write_b16_d16_hi v38, v97 offset:16896
ds_write_b16 v38, v98 offset:10880
ds_write_b16_d16_hi v38, v98 offset:12928
ds_write_b16 v38, v99 offset:14976
ds_write_b16_d16_hi v38, v99 offset:17024
ds_write_b16 v38, v100 offset:11008
ds_write_b16_d16_hi v38, v100 offset:13056
ds_write_b16 v38, v101 offset:15104
ds_write_b16_d16_hi v38, v101 offset:17152
ds_write_b16 v38, v102 offset:11136
ds_write_b16_d16_hi v38, v102 offset:13184
ds_write_b16 v38, v103 offset:15232
ds_write_b16_d16_hi v38, v103 offset:17280
ds_write_b16 v38, v104 offset:11264
ds_write_b16_d16_hi v38, v104 offset:13312
ds_write_b16 v38, v105 offset:15360
ds_write_b16_d16_hi v38, v105 offset:17408
ds_write_b16 v38, v106 offset:11392
ds_write_b16_d16_hi v38, v106 offset:13440
ds_write_b16 v38, v107 offset:15488
ds_write_b16_d16_hi v38, v107 offset:17536
ds_write_b16 v38, v108 offset:11520
ds_write_b16_d16_hi v38, v108 offset:13568
ds_write_b16 v38, v109 offset:15616
ds_write_b16_d16_hi v38, v109 offset:17664
ds_write_b16 v38, v110 offset:11648
ds_write_b16_d16_hi v38, v110 offset:13696
ds_write_b16 v38, v111 offset:15744
ds_write_b16_d16_hi v38, v111 offset:17792
ds_write_b16 v38, v112 offset:11776
ds_write_b16_d16_hi v38, v112 offset:13824
ds_write_b16 v38, v113 offset:15872
ds_write_b16_d16_hi v38, v113 offset:17920
ds_write_b16 v38, v114 offset:11904
ds_write_b16_d16_hi v38, v114 offset:13952
ds_write_b16 v38, v115 offset:16000
ds_write_b16_d16_hi v38, v115 offset:18048
ds_write_b16 v38, v116 offset:12032
ds_write_b16_d16_hi v38, v116 offset:14080
ds_write_b16 v38, v117 offset:16128
ds_write_b16_d16_hi v38, v117 offset:18176
ds_write_b16 v38, v118 offset:12160
ds_write_b16_d16_hi v38, v118 offset:14208
ds_write_b16 v38, v119 offset:16256
ds_write_b16_d16_hi v38, v119 offset:18304
s_branch L_P1_JOIN
L_P1_W13:
s_setprio 3
s_memtime s[40:41]
v_lshlrev_b32 v79, 4, v1
s_lshl_b32 s34, s2, 10
s_add_u32 s34, s34, 0x680000
v_add_u32 v78, s34, v79
v_mov_b32 v75, 27148
s_mov_b32 s34, 43691
v_mov_b32 v74, 87382
s_waitcnt lgkmcnt(0)
s_lshr_b32 s40, s40, 2
s_mul_i32 s40, s40, 0x400800
s_and_b32 s40, s40, 0xf800f800
s_barrier
ds_read_b128 v[80:83], v79 offset:27392
s_waitcnt lgkmcnt(0)
v_mad_u32_u24 v80, v80, s34, v74
v_mad_u32_u24 v81, v81, s34, v74
v_mad_u32_u24 v82, v82, s34, v74
v_mad_u32_u24 v83, v83, s34, v74
v_lshrrev_b32 v80, 17, v80
v_lshrrev_b32 v81, 17, v81
v_lshrrev_b32 v82, 17, v82
v_lshrrev_b32 v83, 17, v83
v_add_u32 v85, v80, v81
v_add3_u32 v84, v85, v82, v83
v_add_u32 v86, v85, v82
v_mov_b32 v87, v84
v_add_u32_dpp v84, v84, v84 row_shr:1 row_mask:0xf bank_mask:0xf bound_ctrl:0
v_mul_u32_u24 v69, 24, v80
v_mul_u32_u24 v70, 24, v85
v_add_u32_dpp v84, v84, v84 row_shr:2 row_mask:0xf bank_mask:0xf bound_ctrl:0
v_mul_u32_u24 v71, 24, v86
v_lshl_or_b32 v83, v83, 16, s40
v_add_u32_dpp v84, v84, v84 row_shr:4 row_mask:0xf bank_mask:0xf bound_ctrl:0
v_lshl_or_b32 v82, v82, 16, s40
v_lshl_or_b32 v81, v81, 16, s40
v_add_u32_dpp v84, v84, v84 row_shr:8 row_mask:0xf bank_mask:0xf bound_ctrl:0
v_add_u32 v83, v83, v86
v_add_u32 v82, v82, v85
v_add_u32_dpp v84, v84, v84 row_bcast:15 row_mask:0xa bank_mask:0xf
v_add_u32 v81, v81, v80
v_lshl_or_b32 v80, v80, 16, s40
v_add_u32_dpp v84, v84, v84 row_bcast:31 row_mask:0xc bank_mask:0xf
v_sub_u32 v85, v84, v87
v_mul_u32_u24 v68, 24, v85
v_add_u32 v69, v69, v68
v_add_u32 v70, v70, v68
v_add_u32 v71, v71, v68
ds_write_b128 v79, v[68:71] offset:27392
s_mov_b32 exec_lo, 0
s_mov_b32 exec_hi, 0x80000000
ds_write_b32 v75, v84
s_mov_b64 exec, -1
v_add_u32 v80, v80, v85
v_add_u32 v81, v81, v85
v_add_u32 v82, v82, v85
v_add_u32 v83, v83, v85
buffer_store_dwordx4 v[80:83], v78, s[12:15], 0 offen sc1
s_waitcnt lgkmcnt(0)
s_barrier
s_mov_b64 exec, 0xff
s_barrier
s_mov_b32 s39, 0
L_RDY:
buffer_load_dword v76, v6, s[16:19], 0 offen sc1
L_RDY1:
s_waitcnt vmcnt(0) lgkmcnt(0)
v_cmp_ne_u32 vcc, 1, v76
s_cbranch_vccz L_RDYX
s_add_u32 s39, s39, 1
s_cmp_ge_u32 s39, 4096
s_cbranch_scc1 L_SLW1
s_branch L_RDY
L_SLW1:
s_cmp_ge_u32 s39, 2097152
s_cbranch_scc1 L_RDYX
s_sleep 64
s_branch L_RDY
L_RDYX:
s_setprio 0
s_mov_b64 exec, -1
L_P1_JOIN:
s_load_dwordx2 s[8:9], s[0:1], 0
s_load_dwordx2 s[62:63], s[0:1], 40
v_lshrrev_b32 v77, 6, v0
s_and_b32 s3, s2, 7
v_readfirstlane_b32 s28, v77
s_lshl_b32 s3, s3, 5
s_lshr_b32 s34, s2, 3
s_or_b32 s3, s3, s34
v_and_b32 v1, 63, v0
v_and_b32 v72, 60, v0
v_lshl_add_u32 v72, v72, 2, s28
s_lshl_b32 s34, s3, 2
s_add_u32 s34, s34, 0x680000
v_lshl_add_u32 v62, v72, 10, s34
s_bfe_u32 s34, s2, 0x40003
s_lshl_b32 s34, s34, 6
v_lshl_add_u32 v64, v1, 10, s34
L_JOIN2:
s_mov_b32 s32, 128
s_mov_b32 s30, 0
s_mov_b32 s37, 0
s_mov_b32 s66, 0
v_mov_b32 v12, 0
v_mov_b32 v13, 0
v_mov_b32 v14, 0
v_mov_b32 v15, 0
v_mov_b32 v16, 0
v_mov_b32 v17, 0
v_mov_b32 v18, 0
v_mov_b32 v19, 0
v_mov_b32 v20, 0
v_mov_b32 v21, 0
v_mov_b32 v22, 0
v_mov_b32 v23, 0
v_and_b32 v76, 7, v0
v_lshlrev_b32 v6, 4, v76
v_and_b32 v76, 1, v0
v_mov_b32 v77, 0x0c0c0302
v_mov_b32 v78, 0x03020c0c
v_cmp_eq_u32 vcc, 1, v76
v_mov_b32 v79, 0x0c0c0c0c
v_and_b32 v76, 2, v0
v_cndmask_b32 v77, v77, v78, vcc
v_cmp_eq_u32 vcc, 2, v76
v_mov_b32 v3, 0
s_and_b32 s34, s2, 7
s_lshl_b32 s34, s34, 8
s_add_u32 s58, s34, 0x770000
s_mov_b32 s10, 0x61a800
v_cndmask_b32 v4, v77, v79, vcc
v_cndmask_b32 v5, v79, v77, vcc
v_cmp_gt_u32 vcc, 200, v0
s_mov_b64 s[52:53], vcc
s_mov_b32 s11, 0x20000
s_add_u32 s16, s12, 0x800000
s_addc_u32 s17, s13, 0
s_mov_b32 s18, 0xc40000
s_mov_b32 s19, 0x20000
s_sub_u32 s56, s28, 1
s_and_b32 s56, s56, 7
s_and_b32 s34, s2, 63
s_lshl_b32 s34, s34, 3
s_add_u32 s56, s56, s34
s_lshl_b32 s56, s56, 7
s_add_u32 s56, s56, 0x740000
s_add_u32 s57, s56, 64
s_mov_b32 s34, 0x740000
s_cmp_lg_u32 s28, 0
s_waitcnt vmcnt(0) lgkmcnt(0)
s_barrier
buffer_load_dword v2, v62, s[12:15], 0 offen sc1
s_cbranch_scc1 L_NOARR
buffer_atomic_add v7, v64, s[12:15], s34 offen sc1
L_NOARR:
s_cmp_eq_u32 s28, 0
s_waitcnt vmcnt(1)
s_cbranch_scc1 L_DECODE
s_cmp_gt_u32 s28, 8
s_waitcnt vmcnt(0)
s_cbranch_scc1 L_DECODE
s_load_dword s48, s[12:13], s56 glc
s_load_dword s49, s[12:13], s57 glc
s_branch L_DECODE
L_BATCH:
s_mov_b32 s66, 2
v_mov_b32 v72, 0
v_mov_b32 v73, 0
v_mov_b32 v74, 0
v_mov_b32 v75, 0
v_lshlrev_b32 v76, 4, v0
v_cmp_gt_u32 vcc, 560, v0
s_mov_b64 exec, vcc
ds_write_b128 v76, v[72:75] offset:18432
s_mov_b64 exec, -1
L_DECODE:
v_and_b32 v73, 60, v0
v_lshl_add_u32 v73, v73, 2, s28
v_mul_u32_u24 v73, 1280, v73
v_and_b32 v75, 3, v0
v_add_u32 v73, v73, v75
s_lshl_b32 s36, s28, 9
s_add_u32 s36, s36, 2048
v_mov_b32 v43, 0
v_mov_b32 v47, 0
v_bfe_u32 v72, v2, 16, 11
v_bfe_u32 v74, v2, 16, 11
v_and_b32 v76, 0x7ff, v2
v_add_u32 v73, v73, v76
v_add_u32_dpp v74, v74, v74 row_shr:4 row_mask:0xf bank_mask:0xf bound_ctrl:0
v_sub_u32 v76, v75, v72
v_subrev_u32 v76, s30, v76
v_add_u32_dpp v74, v74, v74 row_shr:8 row_mask:0xf bank_mask:0xf bound_ctrl:0
v_cmp_lt_u32 s[54:55], v75, v72
v_lshl_add_u32 v60, v1, 2, s36
v_add_u32_dpp v74, v74, v74 row_bcast:15 row_mask:0xa bank_mask:0xf
s_nop 1
v_add_u32_dpp v74, v74, v74 row_bcast:31 row_mask:0xc bank_mask:0xf
s_nop 1
v_readlane_b32 s29, v74, 63
v_add_u32 v76, v76, v74
L_DLOOP:
v_cmp_gt_u32 vcc, s32, v76
v_lshl_add_u32 v77, v76, 2, s36
v_add_u32 v75, 4, v75
v_add_u32 v76, 4, v76
s_and_b64 exec, vcc, s[54:55]
ds_write_b32 v77, v73
s_mov_b64 exec, -1
v_cmp_lt_u32 s[54:55], v75, v72
v_cmp_gt_i32 vcc, s32, v76
v_add_u32 v73, 4, v73
s_and_b64 s[54:55], s[54:55], vcc
s_cbranch_scc1 L_DLOOP
ds_read2st64_b32 v[60:61], v60 offset0:0 offset1:1
s_sub_i32 s36, s29, s30
v_add_u32 v77, 64, v1
v_cmp_gt_i32 s[40:41], s36, v1
v_cmp_gt_i32 s[46:47], s36, v77
s_waitcnt lgkmcnt(0)
v_lshlrev_b32 v60, 4, v60
v_lshlrev_b32 v61, 4, v61
s_cmp_eq_u32 s66, 1
s_cbranch_scc1 L_NOA6
s_cmp_lg_u32 s66, 0
s_cbranch_scc1 L_NORPOLL
s_sub_u32 s34, s28, 1
s_cmp_ge_u32 s34, 8
s_cbranch_scc1 L_NORPOLL
s_mov_b32 s39, 0
s_branch L_BP2c
L_BP2:
s_load_dword s48, s[12:13], s56 glc
s_load_dword s49, s[12:13], s57 glc
s_waitcnt lgkmcnt(0)
L_BP2c:
s_add_u32 s48, s48, s49
s_cmp_eq_u32 s48, 32
s_cbranch_scc1 L_NORPOLL
s_add_u32 s39, s39, 1
s_cmp_ge_u32 s39, 4096
s_cbranch_scc1 L_SLW3
s_branch L_BP2
L_SLW3:
s_cmp_ge_u32 s39, 2097152
s_cbranch_scc1 L_NORPOLL
s_sleep 64
s_branch L_BP2
L_NORPOLL:
s_barrier
L_NOA6:
s_cmp_le_i32 s36, 0
s_cbranch_scc1 L_LD_DONE
s_mov_b64 exec, s[40:41]
buffer_load_dwordx4 v[40:43], v60, s[12:15], 0 offen sc1
s_cmp_le_i32 s36, 64
s_cbranch_scc1 L_LD_DONE
s_mov_b64 exec, s[46:47]
buffer_load_dwordx4 v[44:47], v61, s[12:15], 0 offen sc1
L_LD_DONE:
s_mov_b64 exec, -1
s_cmp_lg_u32 s66, 0
s_cbranch_scc1 L_NOVER
s_barrier
buffer_load_dword v63, v62, s[12:15], 0 offen sc1
s_lshr_b32 s34, s2, 3
s_lshl_b32 s34, s34, 6
s_sub_u32 s35, s28, 11
s_lshl_b32 s35, s35, 11
s_add_u32 s34, s34, s35
v_add_u32 v80, s34, v1
s_and_b32 s34, s2, 7
s_mul_i32 s34, s34, 6272
v_add_u32 v80, s34, v80
v_subrev_u32 v81, 50176, v80
v_min_u32 v80, v80, v81
v_lshlrev_b32 v80, 7, v80
s_waitcnt vmcnt(1)
s_cmp_lt_u32 s28, 11
s_cbranch_scc1 L_NOPF2
buffer_load_dword v31, v80, s[8:11], 0 offen
s_branch L_NOPF2
L_NOVER:
v_mov_b32 v63, v2
s_waitcnt vmcnt(0)
L_NOPF2:
s_mov_b32 s33, 42800
v_bfe_u32 v48, v43, 0, 10
v_bfe_u32 v49, v43, 10, 10
v_bfe_u32 v50, v43, 20, 10
v_cmp_lt_u32 s[40:41], 3, v48
v_mad_u32_u16 v72, v40, s33, 0
v_bfe_u32 v72, v72, 27, 1
v_lshl_or_b32 v48, v48, 1, v72
v_lshlrev_b32 v48, 2, v48
v_cmp_lt_u32 s[42:43], 3, v49
v_mad_u32_u16 v72, v41, s33, 0
v_bfe_u32 v72, v72, 27, 1
v_lshl_or_b32 v49, v49, 1, v72
v_lshlrev_b32 v49, 2, v49
v_cmp_lt_u32 s[44:45], 3, v50
v_mad_u32_u16 v72, v42, s33, 0
v_bfe_u32 v72, v72, 27, 1
v_lshl_or_b32 v50, v50, 1, v72
v_lshlrev_b32 v50, 2, v50
s_mov_b64 exec, s[40:41]
ds_add_rtn_u32 v54, v48, v7 offset:18432
s_mov_b64 exec, s[42:43]
ds_add_rtn_u32 v55, v49, v7 offset:18432
s_mov_b64 exec, s[44:45]
ds_add_rtn_u32 v56, v50, v7 offset:18432
s_cmp_le_i32 s36, 64
s_cbranch_scc1 L_RK_DONE
s_mov_b64 exec, -1
v_bfe_u32 v51, v47, 0, 10
v_bfe_u32 v52, v47, 10, 10
v_bfe_u32 v53, v47, 20, 10
v_cmp_lt_u32 s[46:47], 3, v51
v_mad_u32_u16 v72, v44, s33, 0
v_bfe_u32 v72, v72, 27, 1
v_lshl_or_b32 v51, v51, 1, v72
v_lshlrev_b32 v51, 2, v51
v_cmp_lt_u32 s[48:49], 3, v52
v_mad_u32_u16 v72, v45, s33, 0
v_bfe_u32 v72, v72, 27, 1
v_lshl_or_b32 v52, v52, 1, v72
v_lshlrev_b32 v52, 2, v52
v_cmp_lt_u32 s[50:51], 3, v53
v_mad_u32_u16 v72, v46, s33, 0
v_bfe_u32 v72, v72, 27, 1
v_lshl_or_b32 v53, v53, 1, v72
v_lshlrev_b32 v53, 2, v53
s_mov_b64 exec, s[46:47]
ds_add_rtn_u32 v57, v51, v7 offset:18432
s_mov_b64 exec, s[48:49]
ds_add_rtn_u32 v58, v52, v7 offset:18432
s_mov_b64 exec, s[50:51]
ds_add_rtn_u32 v59, v53, v7 offset:18432
L_RK_DONE:
s_mov_b64 exec, -1
s_cmp_ge_u32 s28, 11
s_waitcnt vmcnt(1)
s_cbranch_scc1 L_VER2
s_waitcnt vmcnt(0)
L_VER2:
v_cmp_ne_u32 vcc, v2, v63
v_mov_b32 v2, v63
s_cmp_lg_u64 vcc, 0
s_cselect_b32 s29, -1, s29
s_mov_b64 exec, 1
v_mov_b32 v77, s29
v_mov_b32 v76, 27140
ds_max_u32 v76, v77
s_mov_b64 exec, -1
v_lshlrev_b32 v82, 5, v0
v_mov_b32 v83, 27136
v_mov_b32 v38, 0xffff
v_mov_b32 v39, 0xffff
s_cmp_ge_u32 s28, 4
s_waitcnt lgkmcnt(0)
s_barrier
s_cbranch_scc1 L_NODE1_DONE
ds_read_b128 v[88:91], v82 offset:18464
ds_read_b128 v[92:95], v82 offset:18480
s_waitcnt lgkmcnt(1)
v_add_u32 v89, v88, v89
v_add_u32 v90, v89, v90
v_add_u32 v91, v90, v91
s_waitcnt lgkmcnt(0)
v_add_u32 v92, v91, v92
v_add_u32 v93, v92, v93
v_add_u32 v94, v93, v94
v_add_u32 v95, v94, v95
v_add_u32 v78, 3, v95
v_lshrrev_b32 v78, 1, v78
v_mov_b32 v76, v95
v_mov_b32 v77, v78
v_add_u32_dpp v78, v78, v78 row_shr:1 row_mask:0xf bank_mask:0xf bound_ctrl:0
v_min_u32 v79, 63, v76
v_sub_u32 v79, 63, v79
v_add_u32_dpp v78, v78, v78 row_shr:2 row_mask:0xf bank_mask:0xf bound_ctrl:0
v_lshlrev_b32 v79, 2, v79
s_mov_b64 exec, s[52:53]
ds_add_rtn_u32 v80, v79, v7 offset:26880
s_mov_b64 exec, -1
v_add_u32_dpp v78, v78, v78 row_shr:4 row_mask:0xf bank_mask:0xf bound_ctrl:0
s_nop 1
v_add_u32_dpp v78, v78, v78 row_shr:8 row_mask:0xf bank_mask:0xf bound_ctrl:0
s_nop 1
v_add_u32_dpp v78, v78, v78 row_bcast:15 row_mask:0xa bank_mask:0xf
s_nop 1
v_add_u32_dpp v78, v78, v78 row_bcast:31 row_mask:0xc bank_mask:0xf
s_nop 1
s_mov_b32 exec_lo, 0
s_mov_b32 exec_hi, 0x80000000
ds_add_rtn_u32 v81, v83, v78
s_mov_b64 exec, -1
v_lshlrev_b32 v78, 1, v78
v_sub_u32 v75, v78, v76
v_lshlrev_b32 v83, 1, v77
v_sub_u32 v78, v78, v83
s_waitcnt lgkmcnt(0)
v_readlane_b32 s34, v81, 63
s_lshl_b32 s34, s34, 3
s_add_u32 s34, s34, 28416
v_lshl_add_u32 v104, v75, 2, s34
v_lshl_add_u32 v105, v88, 2, v104
v_lshl_add_u32 v106, v89, 2, v104
v_lshl_add_u32 v107, v90, 2, v104
ds_write_b128 v82, v[104:107] offset:18464
v_lshl_add_u32 v108, v91, 2, v104
v_lshl_add_u32 v109, v92, 2, v104
v_lshl_add_u32 v110, v93, 2, v104
v_lshl_add_u32 v111, v94, 2, v104
ds_write_b128 v82, v[108:111] offset:18480
v_lshl_add_u32 v78, v78, 2, s34
ds_write_b64 v78, v[38:39]
ds_write_b32 v78, v38 offset:8
L_NODE1_DONE:
v_mov_b32 v72, 27140
v_lshlrev_b32 v73, 2, v1
s_waitcnt lgkmcnt(0)
s_barrier
ds_read_b32 v73, v73 offset:26880
ds_read_b32 v75, v72
ds_read_b32 v48, v48 offset:18432
ds_read_b32 v49, v49 offset:18432
ds_read_b32 v50, v50 offset:18432
s_cmp_le_i32 s36, 64
s_cbranch_scc1 L_RB_DONE
ds_read_b32 v51, v51 offset:18432
ds_read_b32 v52, v52 offset:18432
ds_read_b32 v53, v53 offset:18432
L_RB_DONE:
s_cmp_ge_u32 s28, 4
s_cbranch_scc1 L_NODE2_DONE
s_cmp_lg_u32 s30, 0
s_cbranch_scc1 L_NODE2_NOSORT
s_waitcnt lgkmcnt(4)
v_mov_b32 v72, v73
s_nop 1
v_add_u32_dpp v72, v72, v72 row_shr:1 row_mask:0xf bank_mask:0xf bound_ctrl:0
s_nop 1
v_add_u32_dpp v72, v72, v72 row_shr:2 row_mask:0xf bank_mask:0xf bound_ctrl:0
s_nop 1
v_add_u32_dpp v72, v72, v72 row_shr:4 row_mask:0xf bank_mask:0xf bound_ctrl:0
s_nop 1
v_add_u32_dpp v72, v72, v72 row_shr:8 row_mask:0xf bank_mask:0xf bound_ctrl:0
s_nop 1
v_add_u32_dpp v72, v72, v72 row_bcast:15 row_mask:0xa bank_mask:0xf
s_nop 1
v_add_u32_dpp v72, v72, v72 row_bcast:31 row_mask:0xc bank_mask:0xf
s_nop 1
v_sub_u32 v72, v72, v73
ds_bpermute_b32 v72, v79, v72
s_movk_i32 s34, 160
s_waitcnt lgkmcnt(0)
v_add_u32 v3, v72, v80
v_and_b32 v72, 0xf8, v3
v_add3_u32 v72, v72, v3, s34
v_cmp_gt_u32 vcc, 40, v3
v_subrev_u32 v3, 40, v3
s_nop 0
v_cndmask_b32 v3, v3, v72, vcc
v_lshlrev_b32 v3, 3, v3
L_NODE2_NOSORT:
v_lshl_or_b32 v72, v77, 16, v78
s_mul_i32 s34, s3, 25088
v_lshl_add_u32 v73, v0, 7, s34
v_cmp_gt_u32 vcc, 196, v0
v_mov_b32 v74, 0x80000000
s_mov_b64 exec, s[52:53]
v_cndmask_b32 v73, v74, v73, vcc
ds_write_b64 v3, v[72:73] offset:0
v_cmp_le_u32 vcc, 1280, v3
v_mov_b32 v73, v74
s_and_b64 exec, exec, vcc
ds_write_b64 v3, v[72:73] offset:64
s_mov_b64 exec, -1
L_NODE2_DONE:
s_waitcnt lgkmcnt(0)
s_mov_b64 exec, s[40:41]
v_lshl_add_u32 v54, v54, 2, v48
ds_write_b32 v54, v40
s_mov_b64 exec, s[42:43]
v_lshl_add_u32 v55, v55, 2, v49
ds_write_b32 v55, v41
s_mov_b64 exec, s[44:45]
v_lshl_add_u32 v56, v56, 2, v50
ds_write_b32 v56, v42
s_cmp_le_i32 s36, 64
s_cbranch_scc1 L_RW_DONE
s_mov_b64 exec, s[46:47]
v_lshl_add_u32 v57, v57, 2, v51
ds_write_b32 v57, v44
s_mov_b64 exec, s[48:49]
v_lshl_add_u32 v58, v58, 2, v52
ds_write_b32 v58, v45
s_mov_b64 exec, s[50:51]
v_lshl_add_u32 v59, v59, 2, v53
ds_write_b32 v59, v46
L_RW_DONE:
s_mov_b64 exec, -1
v_readfirstlane_b32 s31, v75
v_lshrrev_b32 v72, 3, v1
s_lshl_b32 s34, s28, 7
v_lshl_add_u32 v72, v72, 3, s34
s_cmp_eq_u32 s31, -1
s_cbranch_scc1 L_NEXTB
s_cmp_ge_u32 s28, 10
s_cselect_b32 s65, 1, 0
s_lshl_b32 s64, 8, s65
s_cmp_ge_u32 s28, 15
s_waitcnt lgkmcnt(0)
s_barrier
s_cbranch_scc1 L_HELPER
ds_read_b64 v[74:75], v72 offset:0
ds_read_b64 v[76:77], v72 offset:64
s_waitcnt lgkmcnt(0)
v_lshrrev_b32 v72, 16, v74
v_lshrrev_b32 v73, 16, v76
v_max_u32 v78, v72, v73
v_and_b32 v25, 0xffff, v74
v_and_b32 v27, 0xffff, v76
v_max_u32_dpp v78, v78, v78 row_ror:8 row_mask:0xf bank_mask:0xf
v_lshl_add_u32 v24, v72, 3, v25
v_lshl_add_u32 v26, v73, 3, v27
v_readlane_b32 s38, v78, 0
v_readlane_b32 s34, v78, 16
v_readlane_b32 s35, v78, 32
v_readlane_b32 s33, v78, 48
s_max_u32 s38, s38, s34
s_max_u32 s33, s33, s35
s_max_u32 s38, s38, s33
s_sub_u32 s38, s38, 1
s_add_u32 s38, s38, s65
s_lshr_b32 s38, s38, s65
s_max_u32 s38, s38, 2
s_mul_i32 s34, s38, s64
s_sub_u32 s35, s34, s64
s_add_u32 s35, s35, 8
v_subrev_u32 v24, s34, v24
v_subrev_u32 v26, s35, v26
s_cmp_lg_u32 s37, 0
s_cbranch_scc1 L_MBENC
v_max_i32 v30, v24, v25
ds_read_b64 v[120:121], v30
v_max_i32 v30, v26, v27
ds_read_b64 v[124:125], v30
v_add_u32 v24, s64, v24
v_add_u32 v26, s64, v26
v_add_u32 v28, v75, v6
v_add_u32 v29, v77, v6
s_sub_u32 s33, s38, 2
s_mul_i32 s56, s38, -1
s_cmp_le_u32 s31, 128
s_cselect_b32 s57, 6, 0
s_waitcnt lgkmcnt(0)
v_mad_u32_u16 v30, v120, s32, v6
v_cmp_ne_u32 vcc, 0xffff, v120
v_mov_b32 v40, 0
v_mov_b32 v41, 0
v_mov_b32 v42, 0
v_mov_b32 v43, 0
s_cbranch_vccz L_SK4
buffer_load_dwordx4 v[40:43], v30, s[8:11], 0 offen
L_SK4:
v_perm_b32 v72, v120, v120, v4
v_perm_b32 v73, v120, v120, v5
v_mad_u32_u16 v30, v124, s32, v6
v_cmp_ne_u32 vcc, 0xffff, v124
v_mov_b32 v44, 0
v_mov_b32 v45, 0
v_mov_b32 v46, 0
v_mov_b32 v47, 0
s_cbranch_vccz L_SK5
buffer_load_dwordx4 v[44:47], v30, s[8:11], 0 offen
L_SK5:
v_perm_b32 v74, v124, v124, v4
v_perm_b32 v75, v124, v124, v5
v_mad_u32_u16 v30, v121, s32, v6
v_cmp_ne_u32 vcc, 0xffff, v121
v_mov_b32 v48, 0
v_mov_b32 v49, 0
v_mov_b32 v50, 0
v_mov_b32 v51, 0
s_cbranch_vccz L_SK6
buffer_load_dwordx4 v[48:51], v30, s[8:11], 0 offen
L_SK6:
v_perm_b32 v76, v121, v121, v4
v_perm_b32 v77, v121, v121, v5
v_mad_u32_u16 v30, v125, s32, v6
v_cmp_ne_u32 vcc, 0xffff, v125
v_mov_b32 v52, 0
v_mov_b32 v53, 0
v_mov_b32 v54, 0
v_mov_b32 v55, 0
s_cbranch_vccz L_SK7
buffer_load_dwordx4 v[52:55], v30, s[8:11], 0 offen
L_SK7:
v_perm_b32 v78, v125, v125, v4
v_perm_b32 v79, v125, v125, v5
v_max_i32 v30, v24, v25
ds_read_b64 v[120:121], v30
v_max_i32 v30, v26, v27
ds_read_b64 v[124:125], v30
v_add_u32 v24, s64, v24
v_add_u32 v26, s64, v26
s_add_i32 s56, s56, 7
L_PACE8a:
s_cmp_lt_i32 s56, 0
s_cbranch_scc1 L_PACE8
s_cmp_eq_u32 s57, 0
s_cbranch_scc1 L_PACE8
s_sub_i32 s56, s56, s38
s_sub_u32 s57, s57, 1
s_barrier
s_branch L_PACE8a
L_PACE8:
s_waitcnt lgkmcnt(0)
v_mad_u32_u16 v30, v120, s32, v6
buffer_load_dwordx4 v[56:59], v30, s[8:11], 0 offen
v_perm_b32 v80, v120, v120, v4
v_perm_b32 v81, v120, v120, v5
v_mad_u32_u16 v30, v124, s32, v6
buffer_load_dwordx4 v[60:63], v30, s[8:11], 0 offen
v_perm_b32 v82, v124, v124, v4
v_perm_b32 v83, v124, v124, v5
v_mad_u32_u16 v30, v121, s32, v6
buffer_load_dwordx4 v[64:67], v30, s[8:11], 0 offen
v_perm_b32 v84, v121, v121, v4
v_perm_b32 v85, v121, v121, v5
v_mad_u32_u16 v30, v125, s32, v6
buffer_load_dwordx4 v[68:71], v30, s[8:11], 0 offen
v_perm_b32 v86, v125, v125, v4
v_perm_b32 v87, v125, v125, v5
v_max_i32 v30, v24, v25
ds_read_b64 v[120:121], v30
v_max_i32 v30, v26, v27
ds_read_b64 v[124:125], v30
v_add_u32 v24, s64, v24
v_add_u32 v26, s64, v26
s_add_i32 s56, s56, 7
L_PACE9a:
s_cmp_lt_i32 s56, 0
s_cbranch_scc1 L_PACE9
s_cmp_eq_u32 s57, 0
s_cbranch_scc1 L_PACE9
s_sub_i32 s56, s56, s38
s_sub_u32 s57, s57, 1
s_barrier
s_branch L_PACE9a
L_PACE9:
s_waitcnt vmcnt(4)
L_GLOOP0:
s_cmp_le_i32 s33, 0
s_cbranch_scc1 L_DRAIN0
s_waitcnt lgkmcnt(0)
v_mad_u32_u16 v30, v120, s32, v6
s_waitcnt vmcnt(7)
v_mfma_f32_4x4x4_16b_bf16 v[8:11], v[72:73], v[40:41], v[8:11]
v_mfma_f32_4x4x4_16b_bf16 v[12:15], v[72:73], v[42:43], v[12:15]
buffer_load_dwordx4 v[40:43], v30, s[8:11], 0 offen
v_perm_b32 v72, v120, v120, v4
v_perm_b32 v73, v120, v120, v5
v_mad_u32_u16 v30, v124, s32, v6
s_waitcnt vmcnt(7)
v_mfma_f32_4x4x4_16b_bf16 v[16:19], v[74:75], v[44:45], v[16:19]
v_mfma_f32_4x4x4_16b_bf16 v[20:23], v[74:75], v[46:47], v[20:23]
buffer_load_dwordx4 v[44:47], v30, s[8:11], 0 offen
v_perm_b32 v74, v124, v124, v4
v_perm_b32 v75, v124, v124, v5
v_mad_u32_u16 v30, v121, s32, v6
s_waitcnt vmcnt(7)
v_mfma_f32_4x4x4_16b_bf16 v[8:11], v[76:77], v[48:49], v[8:11]
v_mfma_f32_4x4x4_16b_bf16 v[12:15], v[76:77], v[50:51], v[12:15]
buffer_load_dwordx4 v[48:51], v30, s[8:11], 0 offen
v_perm_b32 v76, v121, v121, v4
v_perm_b32 v77, v121, v121, v5
v_mad_u32_u16 v30, v125, s32, v6
s_waitcnt vmcnt(7)
v_mfma_f32_4x4x4_16b_bf16 v[16:19], v[78:79], v[52:53], v[16:19]
v_mfma_f32_4x4x4_16b_bf16 v[20:23], v[78:79], v[54:55], v[20:23]
buffer_load_dwordx4 v[52:55], v30, s[8:11], 0 offen
v_perm_b32 v78, v125, v125, v4
v_perm_b32 v79, v125, v125, v5
v_max_i32 v30, v24, v25
ds_read_b64 v[120:121], v30
v_max_i32 v30, v26, v27
ds_read_b64 v[124:125], v30
v_add_u32 v24, s64, v24
v_add_u32 v26, s64, v26
s_add_i32 s56, s56, 7
L_PACE10a:
s_cmp_lt_i32 s56, 0
s_cbranch_scc1 L_PACE10
s_cmp_eq_u32 s57, 0
s_cbranch_scc1 L_PACE10
s_sub_i32 s56, s56, s38
s_sub_u32 s57, s57, 1
s_barrier
s_branch L_PACE10a
L_PACE10:
s_cmp_le_i32 s33, 1
s_cbranch_scc1 L_DRAIN1
s_waitcnt lgkmcnt(0)
v_mad_u32_u16 v30, v120, s32, v6
s_waitcnt vmcnt(7)
v_mfma_f32_4x4x4_16b_bf16 v[8:11], v[80:81], v[56:57], v[8:11]
v_mfma_f32_4x4x4_16b_bf16 v[12:15], v[80:81], v[58:59], v[12:15]
buffer_load_dwordx4 v[56:59], v30, s[8:11], 0 offen
v_perm_b32 v80, v120, v120, v4
v_perm_b32 v81, v120, v120, v5
v_mad_u32_u16 v30, v124, s32, v6
s_waitcnt vmcnt(7)
v_mfma_f32_4x4x4_16b_bf16 v[16:19], v[82:83], v[60:61], v[16:19]
v_mfma_f32_4x4x4_16b_bf16 v[20:23], v[82:83], v[62:63], v[20:23]
buffer_load_dwordx4 v[60:63], v30, s[8:11], 0 offen
v_perm_b32 v82, v124, v124, v4
v_perm_b32 v83, v124, v124, v5
v_mad_u32_u16 v30, v121, s32, v6
s_waitcnt vmcnt(7)
v_mfma_f32_4x4x4_16b_bf16 v[8:11], v[84:85], v[64:65], v[8:11]
v_mfma_f32_4x4x4_16b_bf16 v[12:15], v[84:85], v[66:67], v[12:15]
buffer_load_dwordx4 v[64:67], v30, s[8:11], 0 offen
v_perm_b32 v84, v121, v121, v4
v_perm_b32 v85, v121, v121, v5
v_mad_u32_u16 v30, v125, s32, v6
s_waitcnt vmcnt(7)
v_mfma_f32_4x4x4_16b_bf16 v[16:19], v[86:87], v[68:69], v[16:19]
v_mfma_f32_4x4x4_16b_bf16 v[20:23], v[86:87], v[70:71], v[20:23]
buffer_load_dwordx4 v[68:71], v30, s[8:11], 0 offen
v_perm_b32 v86, v125, v125, v4
v_perm_b32 v87, v125, v125, v5
v_max_i32 v30, v24, v25
ds_read_b64 v[120:121], v30
v_max_i32 v30, v26, v27
ds_read_b64 v[124:125], v30
v_add_u32 v24, s64, v24
v_add_u32 v26, s64, v26
s_add_i32 s56, s56, 7
L_PACE11a:
s_cmp_lt_i32 s56, 0
s_cbranch_scc1 L_PACE11
s_cmp_eq_u32 s57, 0
s_cbranch_scc1 L_PACE11
s_sub_i32 s56, s56, s38
s_sub_u32 s57, s57, 1
s_barrier
s_branch L_PACE11a
L_PACE11:
s_sub_i32 s33, s33, 2
s_branch L_GLOOP0
L_DRAIN0:
s_load_dword s59, s[12:13], s58
s_waitcnt vmcnt(7)
v_mfma_f32_4x4x4_16b_bf16 v[8:11], v[72:73], v[40:41], v[8:11]
v_mfma_f32_4x4x4_16b_bf16 v[12:15], v[72:73], v[42:43], v[12:15]
s_waitcnt vmcnt(6)
v_mfma_f32_4x4x4_16b_bf16 v[16:19], v[74:75], v[44:45], v[16:19]
v_mfma_f32_4x4x4_16b_bf16 v[20:23], v[74:75], v[46:47], v[20:23]
s_waitcnt vmcnt(5)
v_mfma_f32_4x4x4_16b_bf16 v[8:11], v[76:77], v[48:49], v[8:11]
v_mfma_f32_4x4x4_16b_bf16 v[12:15], v[76:77], v[50:51], v[12:15]
s_waitcnt vmcnt(4)
v_mfma_f32_4x4x4_16b_bf16 v[16:19], v[78:79], v[52:53], v[16:19]
v_mfma_f32_4x4x4_16b_bf16 v[20:23], v[78:79], v[54:55], v[20:23]
s_waitcnt vmcnt(3)
v_mfma_f32_4x4x4_16b_bf16 v[8:11], v[80:81], v[56:57], v[8:11]
v_mfma_f32_4x4x4_16b_bf16 v[12:15], v[80:81], v[58:59], v[12:15]
s_waitcnt vmcnt(2)
v_mfma_f32_4x4x4_16b_bf16 v[16:19], v[82:83], v[60:61], v[16:19]
v_mfma_f32_4x4x4_16b_bf16 v[20:23], v[82:83], v[62:63], v[20:23]
s_waitcnt vmcnt(1)
v_mfma_f32_4x4x4_16b_bf16 v[8:11], v[84:85], v[64:65], v[8:11]
v_mfma_f32_4x4x4_16b_bf16 v[12:15], v[84:85], v[66:67], v[12:15]
s_waitcnt vmcnt(0)
v_mfma_f32_4x4x4_16b_bf16 v[16:19], v[86:87], v[68:69], v[16:19]
v_mfma_f32_4x4x4_16b_bf16 v[20:23], v[86:87], v[70:71], v[20:23]
s_branch L_GDONE
L_DRAIN1:
s_load_dword s59, s[12:13], s58
s_waitcnt vmcnt(7)
v_mfma_f32_4x4x4_16b_bf16 v[8:11], v[80:81], v[56:57], v[8:11]
v_mfma_f32_4x4x4_16b_bf16 v[12:15], v[80:81], v[58:59], v[12:15]
s_waitcnt vmcnt(6)
v_mfma_f32_4x4x4_16b_bf16 v[16:19], v[82:83], v[60:61], v[16:19]
v_mfma_f32_4x4x4_16b_bf16 v[20:23], v[82:83], v[62:63], v[20:23]
s_waitcnt vmcnt(5)
v_mfma_f32_4x4x4_16b_bf16 v[8:11], v[84:85], v[64:65], v[8:11]
v_mfma_f32_4x4x4_16b_bf16 v[12:15], v[84:85], v[66:67], v[12:15]
s_waitcnt vmcnt(4)
v_mfma_f32_4x4x4_16b_bf16 v[16:19], v[86:87], v[68:69], v[16:19]
v_mfma_f32_4x4x4_16b_bf16 v[20:23], v[86:87], v[70:71], v[20:23]
s_waitcnt vmcnt(3)
v_mfma_f32_4x4x4_16b_bf16 v[8:11], v[72:73], v[40:41], v[8:11]
v_mfma_f32_4x4x4_16b_bf16 v[12:15], v[72:73], v[42:43], v[12:15]
s_waitcnt vmcnt(2)
v_mfma_f32_4x4x4_16b_bf16 v[16:19], v[74:75], v[44:45], v[16:19]
v_mfma_f32_4x4x4_16b_bf16 v[20:23], v[74:75], v[46:47], v[20:23]
s_waitcnt vmcnt(1)
v_mfma_f32_4x4x4_16b_bf16 v[8:11], v[76:77], v[48:49], v[8:11]
v_mfma_f32_4x4x4_16b_bf16 v[12:15], v[76:77], v[50:51], v[12:15]
s_waitcnt vmcnt(0)
v_mfma_f32_4x4x4_16b_bf16 v[16:19], v[78:79], v[52:53], v[16:19]
v_mfma_f32_4x4x4_16b_bf16 v[20:23], v[78:79], v[54:55], v[20:23]
L_GDONE:
s_waitcnt lgkmcnt(0)
s_add_u32 s30, s30, 128
s_cmp_lt_u32 s30, s31
s_cbranch_scc1 L_NEXTB
s_cmp_eq_u32 s65, 0
s_cbranch_scc1 L_NOCOMB
v_add_f32 v8, v8, v16
v_add_f32 v9, v9, v17
v_add_f32 v10, v10, v18
v_add_f32 v11, v11, v19
v_add_f32 v12, v12, v20
v_add_f32 v13, v13, v21
v_add_f32 v14, v14, v22
v_add_f32 v15, v15, v23
L_NOCOMB:
s_cmp_lg_u32 s37, 0
s_nop 0
v_cvt_pk_bf16_f32 v40, v8, v9
v_cvt_pk_bf16_f32 v41, v10, v11
v_cvt_pk_bf16_f32 v42, v12, v13
v_cvt_pk_bf16_f32 v43, v14, v15
v_cvt_pk_bf16_f32 v44, v16, v17
v_cvt_pk_bf16_f32 v45, v18, v19
v_cvt_pk_bf16_f32 v46, v20, v21
v_cvt_pk_bf16_f32 v47, v22, v23
s_cbranch_scc1 L_EPI
s_mov_b32 s34, 3211264
s_movk_i32 s35, 512
v_cmp_le_u32 vcc, s34, v28
v_and_b32 v48, 0x7fffe000, v28
v_lshrrev_b32 v49, 7, v28
v_add_u32 v50, v48, v28
v_cndmask_b32 v48, 0, -1, vcc
v_xor_b32 v52, v48, v49
v_cmp_le_u32 s[54:55], s34, v29
v_and_b32 v48, 0x7fffe000, v29
v_lshrrev_b32 v49, 7, v29
v_add_u32 v51, v48, v29
v_cndmask_b32 v48, 0, -1, s[54:55]
v_xor_b32 v53, v48, v49
s_mov_b32 s39, 0
s_branch L_QC
L_QP:
s_load_dword s59, s[12:13], s58 glc
s_waitcnt lgkmcnt(0)
L_QC:
s_cmp_lg_u32 s59, 0
s_cbranch_scc1 L_QX
s_add_u32 s39, s39, 1
s_cmp_ge_u32 s39, 4096
s_cbranch_scc1 L_SLW12
s_branch L_QP
L_SLW12:
s_cmp_ge_u32 s39, 2097152
s_cbranch_scc1 L_QX
s_sleep 64
s_branch L_QP
L_QX:
v_bfe_i32 v32, s59, 0, 1
v_xor_b32 v52, v52, v32
v_and_b32 v52, 0x2000, v52
v_or_b32 v50, v50, v52
v_xor_b32 v53, v53, v32
v_and_b32 v53, 0x2000, v53
v_or_b32 v51, v51, v53
v_and_b32 v48, 0x80000380, v28
v_cmp_gt_u32 vcc, s35, v48
v_xor_b32 v52, 0x2000, v50
s_and_saveexec_b64 s[54:55], vcc
s_cbranch_execz L_ST13
buffer_store_dwordx4 v[40:43], v52, s[16:19], 0 offen sc1
L_ST13:
s_mov_b64 exec, -1
v_and_b32 v48, 0x80000380, v29
v_cmp_gt_u32 vcc, s35, v48
v_xor_b32 v53, 0x2000, v51
s_and_saveexec_b64 s[54:55], vcc
s_cbranch_execz L_ST14
buffer_store_dwordx4 v[44:47], v53, s[16:19], 0 offen sc1
L_ST14:
s_mov_b64 exec, -1
buffer_store_dwordx4 v[40:43], v50, s[16:19], 0 offen sc1
s_cmp_lg_u32 s65, 0
s_cbranch_scc1 L_NOHB
buffer_store_dwordx4 v[44:47], v51, s[16:19], 0 offen sc1
L_NOHB:
v_mov_b32 v8, 0
v_mov_b32 v9, 0
v_mov_b32 v10, 0
v_mov_b32 v11, 0
v_mov_b32 v12, 0
v_mov_b32 v13, 0
v_mov_b32 v14, 0
v_mov_b32 v15, 0
v_mov_b32 v16, 0
v_mov_b32 v17, 0
v_mov_b32 v18, 0
v_mov_b32 v19, 0
v_mov_b32 v20, 0
v_mov_b32 v21, 0
v_mov_b32 v22, 0
v_mov_b32 v23, 0
s_add_u32 s34, s38, 1
s_mul_i32 s34, s34, s64
v_subrev_u32 v24, s34, v24
v_subrev_u32 v26, s34, v26
v_lshlrev_b32 v48, 4, v1
ds_read_b128 v[88:91], v48 offset:10240
ds_read_b128 v[92:95], v48 offset:11264
ds_read_b128 v[96:99], v48 offset:12288
ds_read_b128 v[100:103], v48 offset:13312
ds_read_b128 v[104:107], v48 offset:14336
ds_read_b128 v[108:111], v48 offset:15360
ds_read_b128 v[112:115], v48 offset:16384
ds_read_b128 v[116:119], v48 offset:17408
s_lshl_b32 s34, s28, 11
s_add_u32 s34, s34, 83712
v_lshrrev_b32 v48, 3, v1
v_xor_b32 v49, v48, v1
v_and_b32 v49, 7, v49
v_lshlrev_b32 v49, 4, v49
v_lshl_add_u32 v49, v48, 7, v49
v_add_u32 v36, s34, v49
v_and_b32 v48, 15, v1
v_lshrrev_b32 v49, 4, v1
v_xor_b32 v49, v49, v48
v_and_b32 v49, 7, v49
v_lshlrev_b32 v49, 4, v49
v_lshl_add_u32 v49, v48, 7, v49
v_add_u32 v37, s34, v49
v_mov_b32 v48, 27136
ds_read_b32 v48, v48
s_bfe_i32 s60, s2, 0x10002
s_mov_b32 s61, s60
s_movk_i32 s34, 25088
s_movk_i32 s35, 0x2000
v_lshlrev_b32 v49, 4, v0
s_waitcnt lgkmcnt(0)
v_readfirstlane_b32 s39, v48
v_not_b32 v39, v32
s_lshl_b32 s39, s39, 3
s_lshl_b32 s56, s28, 10
L_ENC15:
s_cmp_ge_u32 s56, s39
s_cbranch_scc1 L_ENC15x
ds_read_b128 v[52:55], v49 offset:28416
s_add_u32 s56, s56, 15360
s_waitcnt lgkmcnt(0)
v_and_b32 v56, 0xffff, v52
v_and_b32 v60, 7, v52
v_cmp_le_u32 vcc, s34, v56
v_cmp_gt_u32 s[54:55], 4, v60
v_and_b32 v60, 0xffc0, v52
v_add_lshl_u32 v56, v56, v60, 7
s_andn2_b64 vcc, vcc, s[54:55]
s_and_b64 s[54:55], s[54:55], s[60:61]
s_or_b64 vcc, vcc, s[54:55]
v_cndmask_b32 v60, v32, v39, vcc
v_xor_b32 v60, v60, v52
v_and_or_b32 v56, v60, s35, v56
v_and_b32 v57, 0xffff, v53
v_and_b32 v60, 7, v53
v_cmp_le_u32 vcc, s34, v57
v_cmp_gt_u32 s[54:55], 4, v60
v_and_b32 v60, 0xffc0, v53
v_add_lshl_u32 v57, v57, v60, 7
s_andn2_b64 vcc, vcc, s[54:55]
s_and_b64 s[54:55], s[54:55], s[60:61]
s_or_b64 vcc, vcc, s[54:55]
v_cndmask_b32 v60, v32, v39, vcc
v_xor_b32 v60, v60, v53
v_and_or_b32 v57, v60, s35, v57
v_and_b32 v58, 0xffff, v54
v_and_b32 v60, 7, v54
v_cmp_le_u32 vcc, s34, v58
v_cmp_gt_u32 s[54:55], 4, v60
v_and_b32 v60, 0xffc0, v54
v_add_lshl_u32 v58, v58, v60, 7
s_andn2_b64 vcc, vcc, s[54:55]
s_and_b64 s[54:55], s[54:55], s[60:61]
s_or_b64 vcc, vcc, s[54:55]
v_cndmask_b32 v60, v32, v39, vcc
v_xor_b32 v60, v60, v54
v_and_or_b32 v58, v60, s35, v58
v_and_b32 v59, 0xffff, v55
v_and_b32 v60, 7, v55
v_cmp_le_u32 vcc, s34, v59
v_cmp_gt_u32 s[54:55], 4, v60
v_and_b32 v60, 0xffc0, v55
v_add_lshl_u32 v59, v59, v60, 7
s_andn2_b64 vcc, vcc, s[54:55]
s_and_b64 s[54:55], s[54:55], s[60:61]
s_or_b64 vcc, vcc, s[54:55]
v_cndmask_b32 v60, v32, v39, vcc
v_xor_b32 v60, v60, v55
v_and_or_b32 v59, v60, s35, v59
ds_write_b128 v49, v[56:59] offset:56064
v_add_u32 v49, 15360, v49
s_branch L_ENC15
L_ENC15x:
v_subrev_u32 v48, 512, v0
s_mul_i32 s56, s3, 196
v_add_u32 v52, s56, v48
v_and_b32 v53, 0xffff, v52
v_and_b32 v60, 7, v52
v_cmp_le_u32 vcc, s34, v53
v_cmp_gt_u32 s[54:55], 4, v60
v_and_b32 v60, 0xffc0, v52
v_add_lshl_u32 v53, v53, v60, 7
s_andn2_b64 vcc, vcc, s[54:55]
s_and_b64 s[54:55], s[54:55], s[60:61]
s_or_b64 vcc, vcc, s[54:55]
v_cndmask_b32 v60, v32, v39, vcc
v_xor_b32 v60, v60, v52
v_and_or_b32 v53, v60, s35, v53
L_SYNC2:
s_add_u32 s8, s12, 0x800000
s_addc_u32 s9, s13, 0
s_mov_b32 s10, 0xc40000
s_mov_b32 s11, 0x20000
s_mov_b32 s30, 0
s_mov_b32 s37, 1
s_lshr_b32 s56, s2, 2
s_xnor_b32 s56, s56, s59
s_and_b32 s56, s56, 1
s_lshl_b32 s56, s56, 3
s_and_b32 s34, s2, 0x33
s_or_b32 s56, s56, s34
s_bfe_u32 s34, s2, 0x10003
s_lshl_b32 s34, s34, 2
s_or_b32 s56, s56, s34
s_lshl_b32 s56, s56, 3
s_add_u32 s56, s56, s28
s_lshl_b32 s56, s56, 7
s_add_u32 s56, s56, 0x760000
s_add_u32 s57, s56, 64
s_bfe_u32 s34, s2, 0x40003
s_lshl_b32 s34, s34, 6
v_lshl_add_u32 v54, v1, 10, s34
s_mov_b32 s34, 0x760000
s_cmp_lg_u32 s28, 0
s_waitcnt vmcnt(0) lgkmcnt(0)
s_barrier
s_cbranch_scc1 L_FNB
buffer_atomic_add v7, v54, s[12:15], s34 offen sc1
L_FNB:
s_cmp_lt_u32 s28, 8
s_cbranch_scc1 L_FPOLL
s_cmp_ge_u32 s28, 12
s_cbranch_scc1 L_FDONE
v_cmp_gt_u32 vcc, 196, v48
s_mov_b64 exec, vcc
buffer_load_dword v31, v53, s[8:11], 0 offen sc1
s_mov_b64 exec, -1
s_branch L_FDONE
L_FPOLL:
s_mov_b32 s39, 0
L_BP16:
s_load_dword s48, s[12:13], s56 glc
s_load_dword s49, s[12:13], s57 glc
s_waitcnt lgkmcnt(0)
L_BP16c:
s_add_u32 s48, s48, s49
s_cmp_eq_u32 s48, 32
s_cbranch_scc1 L_FDONE
s_add_u32 s39, s39, 1
s_cmp_ge_u32 s39, 4096
s_cbranch_scc1 L_SLW17
s_branch L_BP16
L_SLW17:
s_cmp_ge_u32 s39, 2097152
s_cbranch_scc1 L_FDONE
s_sleep 64
s_branch L_BP16
L_FDONE:
s_mov_b32 s16, s62
s_mov_b32 s17, s63
s_mov_b32 s18, 0x61a800
s_mov_b32 s19, 0x20000
s_cmp_gt_u32 s31, 128
s_cbranch_scc1 L_C1MB
v_max_i32 v30, v24, v25
ds_read2st64_b64 v[120:123], v30 offset0:0 offset1:54
v_max_i32 v30, v26, v27
ds_read2st64_b64 v[124:127], v30 offset0:0 offset1:54
v_add_u32 v24, s64, v24
v_add_u32 v26, s64, v26
s_barrier
L_G2:
s_sub_u32 s33, s38, 2
s_mul_i32 s56, s38, -1
s_cmp_le_u32 s31, 128
s_cselect_b32 s57, 6, 0
s_waitcnt lgkmcnt(0)
v_add_u32 v30, v122, v6
v_cmp_ne_u32 vcc, 0xffff, v120
v_mov_b32 v40, 0
v_mov_b32 v41, 0
v_mov_b32 v42, 0
v_mov_b32 v43, 0
s_cbranch_vccz L_SK18
buffer_load_dwordx4 v[40:43], v30, s[8:11], 0 offen sc1
L_SK18:
v_perm_b32 v72, v120, v120, v4
v_perm_b32 v73, v120, v120, v5
v_add_u32 v30, v126, v6
v_cmp_ne_u32 vcc, 0xffff, v124
v_mov_b32 v44, 0
v_mov_b32 v45, 0
v_mov_b32 v46, 0
v_mov_b32 v47, 0
s_cbranch_vccz L_SK19
buffer_load_dwordx4 v[44:47], v30, s[8:11], 0 offen sc1
L_SK19:
v_perm_b32 v74, v124, v124, v4
v_perm_b32 v75, v124, v124, v5
v_add_u32 v30, v123, v6
v_cmp_ne_u32 vcc, 0xffff, v121
v_mov_b32 v48, 0
v_mov_b32 v49, 0
v_mov_b32 v50, 0
v_mov_b32 v51, 0
s_cbranch_vccz L_SK20
buffer_load_dwordx4 v[48:51], v30, s[8:11], 0 offen sc1
L_SK20:
v_perm_b32 v76, v121, v121, v4
v_perm_b32 v77, v121, v121, v5
v_add_u32 v30, v127, v6
v_cmp_ne_u32 vcc, 0xffff, v125
v_mov_b32 v52, 0
v_mov_b32 v53, 0
v_mov_b32 v54, 0
v_mov_b32 v55, 0
s_cbranch_vccz L_SK21
buffer_load_dwordx4 v[52:55], v30, s[8:11], 0 offen sc1
L_SK21:
v_perm_b32 v78, v125, v125, v4
v_perm_b32 v79, v125, v125, v5
v_max_i32 v30, v24, v25
ds_read2st64_b64 v[120:123], v30 offset0:0 offset1:54
v_max_i32 v30, v26, v27
ds_read2st64_b64 v[124:127], v30 offset0:0 offset1:54
v_add_u32 v24, s64, v24
v_add_u32 v26, s64, v26
s_add_i32 s56, s56, 7
L_PACE22a:
s_cmp_lt_i32 s56, 0
s_cbranch_scc1 L_PACE22
s_cmp_eq_u32 s57, 0
s_cbranch_scc1 L_PACE22
s_sub_i32 s56, s56, s38
s_sub_u32 s57, s57, 1
s_barrier
s_branch L_PACE22a
L_PACE22:
s_waitcnt lgkmcnt(0)
v_add_u32 v30, v122, v6
buffer_load_dwordx4 v[56:59], v30, s[8:11], 0 offen sc1
v_perm_b32 v80, v120, v120, v4
v_perm_b32 v81, v120, v120, v5
v_add_u32 v30, v126, v6
buffer_load_dwordx4 v[60:63], v30, s[8:11], 0 offen sc1
v_perm_b32 v82, v124, v124, v4
v_perm_b32 v83, v124, v124, v5
v_add_u32 v30, v123, v6
buffer_load_dwordx4 v[64:67], v30, s[8:11], 0 offen sc1
v_perm_b32 v84, v121, v121, v4
v_perm_b32 v85, v121, v121, v5
v_add_u32 v30, v127, v6
buffer_load_dwordx4 v[68:71], v30, s[8:11], 0 offen sc1
v_perm_b32 v86, v125, v125, v4
v_perm_b32 v87, v125, v125, v5
v_max_i32 v30, v24, v25
ds_read2st64_b64 v[120:123], v30 offset0:0 offset1:54
v_max_i32 v30, v26, v27
ds_read2st64_b64 v[124:127], v30 offset0:0 offset1:54
v_add_u32 v24, s64, v24
v_add_u32 v26, s64, v26
s_add_i32 s56, s56, 7
L_PACE23a:
s_cmp_lt_i32 s56, 0
s_cbranch_scc1 L_PACE23
s_cmp_eq_u32 s57, 0
s_cbranch_scc1 L_PACE23
s_sub_i32 s56, s56, s38
s_sub_u32 s57, s57, 1
s_barrier
s_branch L_PACE23a
L_PACE23:
s_waitcnt vmcnt(4)
L_GLOOP1:
s_cmp_le_i32 s33, 0
s_cbranch_scc1 L_DRAIN0
s_waitcnt lgkmcnt(0)
v_add_u32 v30, v122, v6
s_waitcnt vmcnt(7)
v_mfma_f32_4x4x4_16b_bf16 v[8:11], v[72:73], v[40:41], v[8:11]
v_mfma_f32_4x4x4_16b_bf16 v[12:15], v[72:73], v[42:43], v[12:15]
buffer_load_dwordx4 v[40:43], v30, s[8:11], 0 offen sc1
v_perm_b32 v72, v120, v120, v4
v_perm_b32 v73, v120, v120, v5
v_add_u32 v30, v126, v6
s_waitcnt vmcnt(7)
v_mfma_f32_4x4x4_16b_bf16 v[16:19], v[74:75], v[44:45], v[16:19]
v_mfma_f32_4x4x4_16b_bf16 v[20:23], v[74:75], v[46:47], v[20:23]
buffer_load_dwordx4 v[44:47], v30, s[8:11], 0 offen sc1
v_perm_b32 v74, v124, v124, v4
v_perm_b32 v75, v124, v124, v5
v_add_u32 v30, v123, v6
s_waitcnt vmcnt(7)
v_mfma_f32_4x4x4_16b_bf16 v[8:11], v[76:77], v[48:49], v[8:11]
v_mfma_f32_4x4x4_16b_bf16 v[12:15], v[76:77], v[50:51], v[12:15]
buffer_load_dwordx4 v[48:51], v30, s[8:11], 0 offen sc1
v_perm_b32 v76, v121, v121, v4
v_perm_b32 v77, v121, v121, v5
v_add_u32 v30, v127, v6
s_waitcnt vmcnt(7)
v_mfma_f32_4x4x4_16b_bf16 v[16:19], v[78:79], v[52:53], v[16:19]
v_mfma_f32_4x4x4_16b_bf16 v[20:23], v[78:79], v[54:55], v[20:23]
buffer_load_dwordx4 v[52:55], v30, s[8:11], 0 offen sc1
v_perm_b32 v78, v125, v125, v4
v_perm_b32 v79, v125, v125, v5
v_max_i32 v30, v24, v25
ds_read2st64_b64 v[120:123], v30 offset0:0 offset1:54
v_max_i32 v30, v26, v27
ds_read2st64_b64 v[124:127], v30 offset0:0 offset1:54
v_add_u32 v24, s64, v24
v_add_u32 v26, s64, v26
s_add_i32 s56, s56, 7
L_PACE24a:
s_cmp_lt_i32 s56, 0
s_cbranch_scc1 L_PACE24
s_cmp_eq_u32 s57, 0
s_cbranch_scc1 L_PACE24
s_sub_i32 s56, s56, s38
s_sub_u32 s57, s57, 1
s_barrier
s_branch L_PACE24a
L_PACE24:
s_cmp_le_i32 s33, 1
s_cbranch_scc1 L_DRAIN1
s_waitcnt lgkmcnt(0)
v_add_u32 v30, v122, v6
s_waitcnt vmcnt(7)
v_mfma_f32_4x4x4_16b_bf16 v[8:11], v[80:81], v[56:57], v[8:11]
v_mfma_f32_4x4x4_16b_bf16 v[12:15], v[80:81], v[58:59], v[12:15]
buffer_load_dwordx4 v[56:59], v30, s[8:11], 0 offen sc1
v_perm_b32 v80, v120, v120, v4
v_perm_b32 v81, v120, v120, v5
v_add_u32 v30, v126, v6
s_waitcnt vmcnt(7)
v_mfma_f32_4x4x4_16b_bf16 v[16:19], v[82:83], v[60:61], v[16:19]
v_mfma_f32_4x4x4_16b_bf16 v[20:23], v[82:83], v[62:63], v[20:23]
buffer_load_dwordx4 v[60:63], v30, s[8:11], 0 offen sc1
v_perm_b32 v82, v124, v124, v4
v_perm_b32 v83, v124, v124, v5
v_add_u32 v30, v123, v6
s_waitcnt vmcnt(7)
v_mfma_f32_4x4x4_16b_bf16 v[8:11], v[84:85], v[64:65], v[8:11]
v_mfma_f32_4x4x4_16b_bf16 v[12:15], v[84:85], v[66:67], v[12:15]
buffer_load_dwordx4 v[64:67], v30, s[8:11], 0 offen sc1
v_perm_b32 v84, v121, v121, v4
v_perm_b32 v85, v121, v121, v5
v_add_u32 v30, v127, v6
s_waitcnt vmcnt(7)
v_mfma_f32_4x4x4_16b_bf16 v[16:19], v[86:87], v[68:69], v[16:19]
v_mfma_f32_4x4x4_16b_bf16 v[20:23], v[86:87], v[70:71], v[20:23]
buffer_load_dwordx4 v[68:71], v30, s[8:11], 0 offen sc1
v_perm_b32 v86, v125, v125, v4
v_perm_b32 v87, v125, v125, v5
v_max_i32 v30, v24, v25
ds_read2st64_b64 v[120:123], v30 offset0:0 offset1:54
v_max_i32 v30, v26, v27
ds_read2st64_b64 v[124:127], v30 offset0:0 offset1:54
v_add_u32 v24, s64, v24
v_add_u32 v26, s64, v26
s_add_i32 s56, s56, 7
L_PACE25a:
s_cmp_lt_i32 s56, 0
s_cbranch_scc1 L_PACE25
s_cmp_eq_u32 s57, 0
s_cbranch_scc1 L_PACE25
s_sub_i32 s56, s56, s38
s_sub_u32 s57, s57, 1
s_barrier
s_branch L_PACE25a
L_PACE25:
s_sub_i32 s33, s33, 2
s_branch L_GLOOP1
L_C1MB:
s_barrier
s_branch L_BATCH
L_MBENC:
v_lshlrev_b32 v48, 4, v1
ds_read_b128 v[88:91], v48 offset:10240
ds_read_b128 v[92:95], v48 offset:11264
ds_read_b128 v[96:99], v48 offset:12288
ds_read_b128 v[100:103], v48 offset:13312
ds_read_b128 v[104:107], v48 offset:14336
ds_read_b128 v[108:111], v48 offset:15360
ds_read_b128 v[112:115], v48 offset:16384
ds_read_b128 v[116:119], v48 offset:17408
v_mov_b32 v48, 27136
ds_read_b32 v48, v48
s_bfe_i32 s60, s2, 0x10002
s_mov_b32 s61, s60
s_movk_i32 s34, 25088
s_movk_i32 s35, 0x2000
v_lshlrev_b32 v49, 4, v0
s_waitcnt lgkmcnt(0)
v_readfirstlane_b32 s39, v48
v_not_b32 v39, v32
s_lshl_b32 s39, s39, 3
s_lshl_b32 s56, s28, 10
L_ENC26:
s_cmp_ge_u32 s56, s39
s_cbranch_scc1 L_ENC26x
ds_read_b128 v[52:55], v49 offset:28416
s_add_u32 s56, s56, 15360
s_waitcnt lgkmcnt(0)
v_and_b32 v56, 0xffff, v52
v_and_b32 v60, 7, v52
v_cmp_le_u32 vcc, s34, v56
v_cmp_gt_u32 s[54:55], 4, v60
v_and_b32 v60, 0xffc0, v52
v_add_lshl_u32 v56, v56, v60, 7
s_andn2_b64 vcc, vcc, s[54:55]
s_and_b64 s[54:55], s[54:55], s[60:61]
s_or_b64 vcc, vcc, s[54:55]
v_cndmask_b32 v60, v32, v39, vcc
v_xor_b32 v60, v60, v52
v_and_or_b32 v56, v60, s35, v56
v_and_b32 v57, 0xffff, v53
v_and_b32 v60, 7, v53
v_cmp_le_u32 vcc, s34, v57
v_cmp_gt_u32 s[54:55], 4, v60
v_and_b32 v60, 0xffc0, v53
v_add_lshl_u32 v57, v57, v60, 7
s_andn2_b64 vcc, vcc, s[54:55]
s_and_b64 s[54:55], s[54:55], s[60:61]
s_or_b64 vcc, vcc, s[54:55]
v_cndmask_b32 v60, v32, v39, vcc
v_xor_b32 v60, v60, v53
v_and_or_b32 v57, v60, s35, v57
v_and_b32 v58, 0xffff, v54
v_and_b32 v60, 7, v54
v_cmp_le_u32 vcc, s34, v58
v_cmp_gt_u32 s[54:55], 4, v60
v_and_b32 v60, 0xffc0, v54
v_add_lshl_u32 v58, v58, v60, 7
s_andn2_b64 vcc, vcc, s[54:55]
s_and_b64 s[54:55], s[54:55], s[60:61]
s_or_b64 vcc, vcc, s[54:55]
v_cndmask_b32 v60, v32, v39, vcc
v_xor_b32 v60, v60, v54
v_and_or_b32 v58, v60, s35, v58
v_and_b32 v59, 0xffff, v55
v_and_b32 v60, 7, v55
v_cmp_le_u32 vcc, s34, v59
v_cmp_gt_u32 s[54:55], 4, v60
v_and_b32 v60, 0xffc0, v55
v_add_lshl_u32 v59, v59, v60, 7
s_andn2_b64 vcc, vcc, s[54:55]
s_and_b64 s[54:55], s[54:55], s[60:61]
s_or_b64 vcc, vcc, s[54:55]
v_cndmask_b32 v60, v32, v39, vcc
v_xor_b32 v60, v60, v55
v_and_or_b32 v59, v60, s35, v59
ds_write_b128 v49, v[56:59] offset:56064
v_add_u32 v49, 15360, v49
s_branch L_ENC26
L_ENC26x:
s_waitcnt lgkmcnt(0)
s_barrier
v_max_i32 v30, v24, v25
ds_read2st64_b64 v[120:123], v30 offset0:0 offset1:54
v_max_i32 v30, v26, v27
ds_read2st64_b64 v[124:127], v30 offset0:0 offset1:54
v_add_u32 v24, s64, v24
v_add_u32 v26, s64, v26
s_branch L_G2
L_EPI:
ds_write_b128 v36, v[40:43]
ds_write_b128 v36, v[44:47] offset:1024
v_xor_b32 v30, 64, v37
ds_read_b128 v[40:43], v37
ds_read_b128 v[44:47], v30
v_lshrrev_b32 v30, 3, v1
s_lshl_b32 s34, s28, 7
v_lshl_add_u32 v30, v30, 4, s34
ds_read_b128 v[48:51], v30 offset:0
s_mov_b32 vcc_lo, 0x00ff00ff
s_mov_b32 vcc_hi, 0x00ff00ff
s_waitcnt lgkmcnt(2)
v_mfma_f32_16x16x32_bf16 v[8:11], v[40:43], v[88:91], 0
v_mfma_f32_16x16x32_bf16 v[12:15], v[40:43], v[96:99], 0
v_mfma_f32_16x16x32_bf16 v[16:19], v[40:43], v[104:107], 0
v_mfma_f32_16x16x32_bf16 v[20:23], v[40:43], v[112:115], 0
s_waitcnt lgkmcnt(1)
v_mfma_f32_16x16x32_bf16 v[8:11], v[44:47], v[92:95], v[8:11]
v_mfma_f32_16x16x32_bf16 v[12:15], v[44:47], v[100:103], v[12:15]
v_mfma_f32_16x16x32_bf16 v[16:19], v[44:47], v[108:111], v[16:19]
v_mfma_f32_16x16x32_bf16 v[20:23], v[44:47], v[116:119], v[20:23]
s_waitcnt lgkmcnt(0)
v_add_u32 v48, v49, v6
v_add_u32 v50, v51, v6
s_nop 2
v_cvt_pk_bf16_f32 v56, v8, v12
v_cvt_pk_bf16_f32 v58, v9, v13
v_cvt_pk_bf16_f32 v60, v10, v14
v_cvt_pk_bf16_f32 v62, v11, v15
v_cvt_pk_bf16_f32 v57, v16, v20
v_cvt_pk_bf16_f32 v59, v17, v21
v_cvt_pk_bf16_f32 v61, v18, v22
v_cvt_pk_bf16_f32 v63, v19, v23
v_cndmask_b32_dpp v64, v60, v56, vcc row_ror:8 row_mask:0xf bank_mask:0xf
v_cndmask_b32_dpp v68, v62, v58, vcc row_ror:8 row_mask:0xf bank_mask:0xf
v_cndmask_b32_dpp v65, v61, v57, vcc row_ror:8 row_mask:0xf bank_mask:0xf
v_cndmask_b32_dpp v69, v63, v59, vcc row_ror:8 row_mask:0xf bank_mask:0xf
s_not_b64 vcc, vcc
v_cndmask_b32_dpp v66, v56, v60, vcc row_ror:8 row_mask:0xf bank_mask:0xf
v_cndmask_b32_dpp v67, v57, v61, vcc row_ror:8 row_mask:0xf bank_mask:0xf
buffer_store_dwordx4 v[64:67], v48, s[16:19], 0 offen sc1
v_cndmask_b32_dpp v70, v58, v62, vcc row_ror:8 row_mask:0xf bank_mask:0xf
v_cndmask_b32_dpp v71, v59, v63, vcc row_ror:8 row_mask:0xf bank_mask:0xf
buffer_store_dwordx4 v[68:71], v50, s[16:19], 0 offen sc1
L_FIN:
s_endpgm
L_HELPER:
s_xor_b32 s34, s28, 15
s_xor_b32 s35, s2, 255
s_or_b32 s34, s34, s35
s_or_b32 s34, s34, s30
s_or_b32 s34, s34, s37
s_cbranch_scc1 L_HELP1
s_mov_b32 s34, 0x760000
s_mov_b32 s33, 0
L_PRB:
s_add_u32 s35, s34, 8192
s_memtime s[40:41]
s_load_dword s46, s[12:13], s34 glc
s_waitcnt lgkmcnt(0)
s_memtime s[42:43]
s_load_dword s46, s[12:13], s35 glc
s_waitcnt lgkmcnt(0)
s_memtime s[44:45]
s_lshl_b32 s42, s42, 1
s_sub_u32 s40, s42, s40
s_waitcnt lgkmcnt(0)
s_sub_u32 s40, s40, s44
s_lshr_b32 s40, s40, 31
s_add_u32 s33, s33, s40
s_addk_i32 s34, 1280
s_cmp_lt_u32 s34, 0x760f00
s_cbranch_scc1 L_PRB
s_cmp_gt_u32 s33, 1
s_cselect_b32 s34, 2, 3
v_mov_b32 v40, s34
v_lshlrev_b32 v41, 8, v1
s_mov_b32 s34, 0x770000
s_mov_b64 exec, 0xff
buffer_store_dword v40, v41, s[12:15], s34 offen sc1
s_mov_b64 exec, -1
L_HELP1:
s_cmp_le_u32 s31, 128
s_cbranch_scc1 L_FIN
s_cmp_eq_u32 s37, 0
s_cbranch_scc1 L_HELP2
s_barrier
L_HELP2:
s_add_u32 s30, s30, 128
s_cmp_lt_u32 s30, s31
s_cbranch_scc1 L_NEXTB
s_cmp_lg_u32 s37, 0
s_cbranch_scc1 L_FIN
v_mov_b32 v53, 0
s_branch L_SYNC2
L_NEXTB:
s_waitcnt vmcnt(0) lgkmcnt(0)
s_barrier
s_branch L_BATCH
L_END:
s_endpgm
.section .rodata,"a"
.p2align 6
.amdhsa_kernel standalone__spectral_conv_sgc__graph_kernel
  .amdhsa_next_free_vgpr 128
  .amdhsa_next_free_sgpr 68
  .amdhsa_accum_offset 128
  .amdhsa_group_segment_fixed_size 0
  .amdhsa_kernarg_size 64
  .amdhsa_user_sgpr_count 2
  .amdhsa_user_sgpr_kernarg_segment_ptr 1
  .amdhsa_system_sgpr_workgroup_id_x 1
  .amdhsa_float_denorm_mode_32 3
.end_amdhsa_kernel
```
